```python
import torch

def _softmax(x, axis=-1):
    return torch.softmax(x, dim=axis)
def _gelu(x):
    return torch.nn.functional.gelu(x, approximate="tanh")
def _silu(x):
    return torch.nn.functional.silu(x)
def _sigmoid(x):
    return torch.sigmoid(x)
def _layernorm(x, axis=-1, eps=1e-5):
    m = x.mean(dim=axis, keepdim=True)
    v = x.var(dim=axis, keepdim=True, unbiased=False)
    return (x - m) / torch.sqrt(v + eps)
def _scatter_add(tgt, idx, src, axis=0):
    return tgt.clone().index_add_(axis, idx, src)
def _segment_sum(src, seg, n):
    out = torch.zeros((n,) + src.shape[1:], dtype=src.dtype)
    return out.index_add_(0, seg, src)
def _pad(x, pw):
    flat = tuple(v for pair in reversed(pw) for v in pair)
    return torch.nn.functional.pad(x, flat)

kernel_name = 'standalone__spectral_fnet__prompt'

def setup_inputs():

    _w = (lambda a: (lambda t: t.to(torch.bfloat16) if t.is_floating_point() else t)(torch.as_tensor(a)))
    B, S, D = 1, 2048, 640
    ns = torch.arange(S)[:, None] * torch.arange(S)[None, :]
    nd = torch.arange(D)[:, None] * torch.arange(D)[None, :]
    Ws_re = torch.cos(-2.0 * torch.pi * ns / S).to(float)
    Ws_im = torch.sin(-2.0 * torch.pi * ns / S).to(float)
    Wd_re = torch.cos(-2.0 * torch.pi * nd / D).to(float)
    Wd_im = torch.sin(-2.0 * torch.pi * nd / D).to(float)
    return {
        "x": _w((lambda *s: torch.randn(*s, dtype=torch.bfloat16) * 0.05)(B, S, D)),
        "dft_seq_re": _w(Ws_re),
        "dft_seq_im": _w(Ws_im),
        "dft_hid_re": _w(Wd_re),
        "dft_hid_im": _w(Wd_im),
    }

def reference(x, dft_seq_re, dft_seq_im, dft_hid_re, dft_hid_im):
    a = torch.einsum("bsd,ed->bse", x, dft_hid_re)
    b = torch.einsum("bsd,ed->bse", x, dft_hid_im)
    y = torch.einsum("ts,bse->bte", dft_seq_re, a) - torch.einsum("ts,bse->bte", dft_seq_im, b)
    return y
```

```asm
; @launch grid=(256,1,1) block=(576,1,1) lds=54016
.amdgcn_target "amdgcn-amd-amdhsa--gfx950"
.text
.globl standalone__spectral_fnet__prompt_kernel
.p2align 8
.type standalone__spectral_fnet__prompt_kernel,@function
standalone__spectral_fnet__prompt_kernel:
    s_load_dwordx2 s[8:9], s[0:1], 0
    s_load_dwordx2 s[6:7], s[0:1], 56
    v_readfirstlane_b32 s3, v0
    s_and_b32 s28, s2, 7
    s_lshr_b32 s27, s2, 3
    s_cmp_lt_u32 s27, 30
    s_cbranch_scc1 L_nopf
    s_getpc_b64 s[20:21]
L_pc:
    v_min_u32 v9, 37, v0
    v_lshlrev_b32 v9, 7, v9
    global_load_dword v163, v9, s[20:21]
L_nopf:
    s_mul_i32 s32, s28, 20
    s_add_u32 s32, s32, s27
    s_mul_i32 s34, s3, 5
    s_lshr_b32 s3, s3, 6
    s_add_u32 s33, s27, 1240
    s_cmp_lt_u32 s27, 20
    s_cselect_b32 s33, 0, s33
    s_cselect_b32 s29, 8, 4
    s_add_u32 s33, s33, s32
    s_add_u32 s33, s33, s34
    s_lshl_b32 s33, s33, 6
    s_cmp_lt_u32 s3, s29
    s_cselect_b32 s29, 30, 0
    s_cmp_lt_u32 s27, s29
    s_cselect_b32 s10, 2621440, 0
    s_mov_b32 s11, 0x20000
    v_and_b32 v7, 48, v0
    v_and_b32 v1, 15, v0
    s_movk_i32 s34, 10240
    v_mad_u32_u24 v2, v7, s34, v1
    v_lshlrev_b32 v2, 2, v2
    v_add_u32 v3, s34, v2
    s_lshl_b32 s34, s34, 4
    s_waitcnt lgkmcnt(0)
    buffer_load_dword v32, v2, s[8:11], s33 offen nt
    buffer_load_dword v36, v3, s[8:11], s33 offen nt
    s_add_u32 s33, s33, s34
    buffer_load_dword v33, v2, s[8:11], s33 offen nt
    buffer_load_dword v37, v3, s[8:11], s33 offen nt
    s_add_u32 s33, s33, s34
    buffer_load_dword v34, v2, s[8:11], s33 offen nt
    buffer_load_dword v38, v3, s[8:11], s33 offen nt
    s_add_u32 s33, s33, s34
    buffer_load_dword v35, v2, s[8:11], s33 offen nt
    buffer_load_dword v39, v3, s[8:11], s33 offen nt
    s_load_dword s47, s[6:7], 524288
L_ldend:
    s_load_dwordx2 s[24:25], s[0:1], 40
    s_cmp_ge_u32 s27, 32
    s_cbranch_scc1 L_done
    s_cmp_eq_u32 s3, 8
    s_cbranch_scc1 L_svc
    v_cvt_f32_u32 v4, v1
    v_lshlrev_b32 v11, 8, v7
    v_lshrrev_b32 v17, 2, v7
    v_cvt_f32_u32 v7, v7
    v_mul_f32 v4, 0x3c000000, v4
    s_lshr_b32 s35, s3, 1
    s_and_b32 s26, s3, 1
    v_add_f32 v7, v7, v7
    s_lshl_b32 s40, s35, 8
    s_lshl_b32 s41, s26, 3
    s_add_u32 s40, s40, s41
    v_mul_f32 v5, v7, v4
    v_cos_f32 v27, v5
    v_sin_f32 v28, v5
    v_fmamk_f32 v29, v4, 0x41000000, v5
    v_cos_f32 v30, v29
    v_sin_f32 v31, v29
    v_cvt_pk_bf16_f32 v60, v27, v28
    v_cvt_pk_bf16_f32 v64, -v28, v27
    v_fmamk_f32 v26, v4, 0x41800000, v5
    v_cos_f32 v27, v26
    v_sin_f32 v28, v26
    v_cvt_pk_bf16_f32 v61, v30, v31
    v_cvt_pk_bf16_f32 v65, -v31, v30
    v_fmamk_f32 v29, v4, 0x41c00000, v5
    v_cos_f32 v30, v29
    v_sin_f32 v31, v29
    v_cvt_pk_bf16_f32 v62, v27, v28
    v_cvt_pk_bf16_f32 v66, -v28, v27
    v_cvt_f32_u32 v2, s3
    v_cvt_pk_bf16_f32 v63, v30, v31
    v_cvt_pk_bf16_f32 v67, -v31, v30
    v_lshl_add_u32 v11, v1, 4, v11
    s_cmp_lg_u32 s3, 0
    v_add_u32 v11, s40, v11
    s_cbranch_scc0 L_w0f
    v_fmamk_f32 v4, v2, 0x3a000000, v4
    v_mul_f32 v5, v7, v4
    v_cos_f32 v27, v5
    v_sin_f32 v28, v5
    v_fmamk_f32 v29, v4, 0x41000000, v5
    v_cos_f32 v30, v29
    v_sin_f32 v31, v29
    v_cvt_pk_bf16_f32 v44, v27, v28
    v_cvt_pk_bf16_f32 v52, -v28, v27
    v_cvt_pk_bf16_f32 v48, v27, -v28
    v_cvt_pk_bf16_f32 v56, v28, v27
    v_fmamk_f32 v26, v4, 0x41800000, v5
    v_cos_f32 v27, v26
    v_sin_f32 v28, v26
    v_cvt_pk_bf16_f32 v45, v30, v31
    v_cvt_pk_bf16_f32 v53, -v31, v30
    v_cvt_pk_bf16_f32 v49, v30, -v31
    v_cvt_pk_bf16_f32 v57, v31, v30
    v_fmamk_f32 v29, v4, 0x41c00000, v5
    v_cos_f32 v30, v29
    v_sin_f32 v31, v29
    v_cvt_pk_bf16_f32 v46, v27, v28
    v_cvt_pk_bf16_f32 v54, -v28, v27
    v_cvt_pk_bf16_f32 v50, v27, -v28
    v_cvt_pk_bf16_f32 v58, v28, v27
    v_cvt_pk_bf16_f32 v47, v30, v31
    v_cvt_pk_bf16_f32 v55, -v31, v30
    v_cvt_pk_bf16_f32 v51, v30, -v31
    v_cvt_pk_bf16_f32 v59, v31, v30
L_w0f_back:
    v_and_b32 v6, 63, v0
    s_movk_i32 s41, 20608
    v_lshlrev_b32 v15, 3, v1
    v_lshlrev_b32 v6, 4, v6
    v_mad_u32_u24 v10, v17, s41, v15
    s_lshl_b32 s40, s3, 10
    s_sub_u32 s41, 16384, s40
    s_cmp_eq_u32 s3, 0
    s_cselect_b32 s41, 8192, s41
    v_add_u32 v12, s40, v6
    v_add_u32 v13, s41, v6
    s_add_u32 s12, s6, 1048576
    s_addc_u32 s13, s7, 0
    s_cmp_lt_u32 s27, 20
    s_cselect_b32 s14, 2637824, 0
    s_mov_b32 s15, 0x20000
    s_cselect_b32 s29, s32, 0
    s_and_b32 s29, s29, 15
    s_lshl_b32 s29, s29, 4
    s_add_u32 s29, s29, s3
    s_lshr_b32 s31, s32, 4
    s_lshl_b32 s32, s32, 7
    s_mul_i32 s33, s3, 329728
    s_add_u32 s32, s32, s33
    s_mov_b32 s27, s35
    s_add_u32 s33, s32, 20608
    s_add_u32 s34, s32, 41216
    s_add_u32 s35, s32, 61824
    v_lshlrev_b32 v2, 1, v1
    s_mov_b64 exec, 0
    s_cmp_eq_u32 s3, 1
    s_cbranch_scc1 L_pad0
    s_cmp_eq_u32 s3, 2
    s_cbranch_scc1 L_pad1
    s_cmp_eq_u32 s3, 3
    s_cbranch_scc1 L_pad2
    s_cmp_eq_u32 s3, 4
    s_cbranch_scc1 L_pad3
    s_cmp_eq_u32 s3, 5
    s_cbranch_scc1 L_pad4
    s_cmp_eq_u32 s3, 6
    s_cbranch_scc1 L_pad5
    s_cmp_eq_u32 s3, 7
    s_cbranch_scc1 L_pad6
L_ret0:
    s_mov_b64 exec, -1
    s_waitcnt lgkmcnt(0)
    s_not_b32 s47, s47
    v_lshrrev_b32 v24, v2, s47
    s_cmp_eq_u32 s29, 103
    v_lshrrev_b32 v25, 1, v24
    s_cbranch_scc1 L_hint
    s_waitcnt vmcnt(0)
L_hint_back:
    v_mfma_f32_16x16x32_bf16 v[72:75], v[60:63], v[32:35], 0
    v_mfma_f32_16x16x32_bf16 v[84:87], v[64:67], v[32:35], 0
    v_mfma_f32_16x16x32_bf16 v[76:79], v[60:63], v[36:39], 0
    v_mfma_f32_16x16x32_bf16 v[88:91], v[64:67], v[36:39], 0
    s_cmp_lg_u32 s3, 0
    s_nop 4
    v_cvt_pk_bf16_f32 v96, v72, v84
    v_cvt_pk_bf16_f32 v98, v73, v85
    v_cvt_pk_bf16_f32 v100, v74, v86
    v_cvt_pk_bf16_f32 v102, v75, v87
    v_cvt_pk_bf16_f32 v97, v76, v88
    ds_write_b64 v11, v[96:97] offset:0
    v_cvt_pk_bf16_f32 v99, v77, v89
    ds_write_b64 v11, v[98:99] offset:1024
    v_cvt_pk_bf16_f32 v101, v78, v90
    ds_write_b64 v11, v[100:101] offset:2048
    v_cvt_pk_bf16_f32 v103, v79, v91
    ds_write_b64 v11, v[102:103] offset:3072
    s_waitcnt lgkmcnt(0)
    s_barrier
L_reg0:
    ds_read_b128 v[36:39], v13
    ds_read_b128 v[32:35], v12
    s_waitcnt lgkmcnt(1)
    v_mfma_f32_16x16x32_bf16 v[76:79], v[48:51], v[36:39], 0
    v_mfma_f32_16x16x32_bf16 v[88:91], v[56:59], v[36:39], 0
    s_waitcnt lgkmcnt(0)
    v_mfma_f32_16x16x32_bf16 v[72:75], v[44:47], v[32:35], 0
    v_mfma_f32_16x16x32_bf16 v[84:87], v[52:55], v[32:35], 0
    s_cbranch_scc0 L_w0st
    s_nop 3
    v_cvt_pk_bf16_f32 v97, v76, v88
    v_cvt_pk_bf16_f32 v99, v77, v89
    v_cvt_pk_bf16_f32 v101, v78, v90
    v_cvt_pk_bf16_f32 v103, v79, v91
    v_cvt_pk_bf16_f32 v96, v72, v84
    v_bfi_b32 v97, 1, v25, v97
    v_bfi_b32 v96, 1, v24, v96
    buffer_store_dwordx2 v[96:97], v10, s[12:15], s32 offen sc1
    v_cvt_pk_bf16_f32 v98, v73, v85
    v_bfi_b32 v99, 1, v25, v99
    v_bfi_b32 v98, 1, v24, v98
    buffer_store_dwordx2 v[98:99], v10, s[12:15], s33 offen sc1
    v_cvt_pk_bf16_f32 v100, v74, v86
    v_bfi_b32 v101, 1, v25, v101
    v_bfi_b32 v100, 1, v24, v100
    buffer_store_dwordx2 v[100:101], v10, s[12:15], s34 offen sc1
    v_cvt_pk_bf16_f32 v102, v75, v87
    v_bfi_b32 v103, 1, v25, v103
    v_bfi_b32 v102, 1, v24, v102
    buffer_store_dwordx2 v[102:103], v10, s[12:15], s35 offen sc1
    s_branch L_st_done
L_w0st:
    s_nop 3
    v_cvt_pk_bf16_f32 v97, v76, v88
    v_cvt_pk_bf16_f32 v99, v77, v89
    v_cvt_pk_bf16_f32 v101, v78, v90
    v_cvt_pk_bf16_f32 v103, v79, v91
L_pad0:
    s_cbranch_execz L_ret0
    v_cvt_pk_bf16_f32 v96, v72, v84
    v_cvt_pk_bf16_f32 v98, v73, v85
    v_cvt_pk_bf16_f32 v100, v74, v86
    v_cvt_pk_bf16_f32 v102, v75, v87
    v_permlane32_swap_b32 v96, v97
    v_permlane32_swap_b32 v98, v99
    v_permlane32_swap_b32 v100, v101
    v_permlane32_swap_b32 v102, v103
    v_bfi_b32 v97, 1, v25, v97
    v_bfi_b32 v96, 1, v24, v96
    buffer_store_dwordx2 v[96:97], v10, s[12:15], s32 offen sc1
    v_bfi_b32 v99, 1, v25, v99
    v_bfi_b32 v98, 1, v24, v98
    buffer_store_dwordx2 v[98:99], v10, s[12:15], s33 offen sc1
    v_bfi_b32 v101, 1, v25, v101
    v_bfi_b32 v100, 1, v24, v100
    buffer_store_dwordx2 v[100:101], v10, s[12:15], s34 offen sc1
    v_bfi_b32 v103, 1, v25, v103
    v_bfi_b32 v102, 1, v24, v102
    buffer_store_dwordx2 v[102:103], v10, s[12:15], s35 offen sc1
L_st_done:
    s_mov_b64 s[8:9], s[12:13]
    s_mov_b32 s10, 2637824
    s_lshr_b32 s41, s2, 4
    s_lshl_b32 s41, s41, 3
    s_add_u32 s40, s28, s41
    s_mul_i32 s44, s40, 20608
    s_lshl_b32 s41, s3, 7
    s_add_u32 s45, s44, s41
    s_add_u32 s44, s45, s41
    s_add_u32 s45, s45, 1536
    v_mul_u32_u24 v14, 1280, v17
    v_add_u32 v3, v14, v15
    v_add_u32 v14, v3, v15
    v_mov_b32 v15, v3
    s_lshl_b32 s41, s27, 4
    s_sub_u32 s41, s41, 16
    s_mov_b32 s43, 0x3ccccccd
    s_mul_i32 s42, s27, 3072
    s_lshl_b32 s46, s26, 2
    s_add_u32 s42, s42, s46
    s_cmp_eq_u32 s27, 0
    s_cmov_b32 s41, 0
L_pad1:
    s_cbranch_execz L_ret0
    s_cmov_b32 s43, 0x3acccccd
    v_add_u32 v2, s41, v1
    v_cvt_f32_u32 v5, s26
    v_cvt_f32_u32 v2, v2
    v_fmamk_f32 v5, v7, 0x3d800000, v5
    v_mul_f32 v4, s43, v2
    v_add_u32 v2, s42, v6
    v_mul_f32 v5, v5, v4
    v_cos_f32 v44, v5
    v_sin_f32 v45, v5
    v_fmamk_f32 v29, v4, 0x41000000, v5
    v_cos_f32 v46, v29
    v_sin_f32 v47, v29
    v_fmamk_f32 v26, v4, 0x41800000, v5
    v_cos_f32 v48, v26
    v_sin_f32 v49, v26
    v_fmamk_f32 v29, v4, 0x41c00000, v5
    v_cos_f32 v50, v29
    v_sin_f32 v51, v29
    v_fmamk_f32 v26, v4, 0x42000000, v5
    v_cos_f32 v52, v26
    v_sin_f32 v53, v26
    s_cbranch_scc1 L_tw
    v_cvt_pk_bf16_f32 v44, v44, v45
    ds_write_b32 v2, v44 offset:40704
    v_cvt_pk_bf16_f32 v46, v46, v47
    ds_write_b32 v2, v46 offset:40712
    v_cvt_pk_bf16_f32 v48, v48, v49
    ds_write_b32 v2, v48 offset:41728
    v_cvt_pk_bf16_f32 v50, v50, v51
    ds_write_b32 v2, v50 offset:41736
    v_cvt_pk_bf16_f32 v52, v52, v53
    ds_write_b32 v2, v52 offset:42752
    s_branch L_tab_done
L_tw:
    v_mul_f32 v44, 0.5, v44
    v_mul_f32 v45, 0.5, v45
    ds_write_b32 v2, v44 offset:38656
    ds_write_b32 v2, v45 offset:38664
    v_mul_f32 v46, 0.5, v46
    v_mul_f32 v47, 0.5, v47
    ds_write_b32 v2, v46 offset:39680
    ds_write_b32 v2, v47 offset:39688
    v_mul_f32 v48, 0.5, v48
    v_mul_f32 v49, 0.5, v49
L_pad2:
    s_cbranch_execz L_ret0
    ds_write_b32 v2, v48 offset:40704
    ds_write_b32 v2, v49 offset:40712
    v_mul_f32 v50, 0.5, v50
    v_mul_f32 v51, 0.5, v51
    ds_write_b32 v2, v50 offset:41728
    ds_write_b32 v2, v51 offset:41736
    v_mul_f32 v52, 0.5, v52
    v_mul_f32 v53, 0.5, v53
    ds_write_b32 v2, v52 offset:42752
    ds_write_b32 v2, v53 offset:42760
L_tab_done:
    s_lshr_b32 s41, s40, 4
    s_and_b32 s42, s40, 15
    s_lshl_b32 s42, s42, 4
    s_add_u32 s42, s42, s41
    s_sub_u32 s43, s42, 120
    s_and_b32 s41, s40, 0x78
    s_cmp_eq_u32 s41, 8
    s_cselect_b32 s42, s43, s42
    s_sub_u32 s43, 256, s42
    s_cmp_eq_u32 s40, 0
    s_cselect_b32 s43, 128, s43
    s_bitcmp1_b32 s2, 3
    s_cselect_b32 s42, s43, s42
    s_cselect_b32 s46, -1, 0
    s_waitcnt lgkmcnt(0)
    s_barrier
    v_lshlrev_b32 v5, 2, v1
    v_lshrrev_b32 v26, v5, s47
    v_lshrrev_b32 v27, 1, v26
    v_lshrrev_b32 v28, 2, v26
    v_lshrrev_b32 v29, 3, v26
    v_lshrrev_b32 v2, 2, v17
    v_and_b32 v3, 2, v2
    s_movk_i32 s30, 277
    v_add_u32 v2, 1024, v2
    v_lshl_add_u32 v12, s3, 4, v1
    v_add_u32 v11, v2, v3
    v_lshrrev_b32 v2, 1, v12
    v_mul_u32_u24 v4, 205, v2
    v_mad_u32_u24 v5, v2, s30, v11
    v_lshrrev_b32 v4, 10, v4
    v_and_b32 v2, 1, v1
    v_mul_u32_u24 v4, 1368, v4
    v_lshlrev_b32 v2, 3, v2
    v_sub_u32 v5, v5, v4
    v_lshl_add_u32 v18, v5, 4, v2
    v_lshrrev_b32 v2, 2, v12
L_pad3:
    s_cbranch_execz L_ret0
    v_add_u32 v2, 48, v2
    v_mul_u32_u24 v4, 205, v2
    v_mad_u32_u24 v5, v2, s30, v11
    v_lshrrev_b32 v4, 10, v4
    v_and_b32 v2, 3, v1
    v_mul_u32_u24 v4, 1368, v4
    v_lshlrev_b32 v2, 2, v2
    v_sub_u32 v5, v5, v4
    v_lshl_add_u32 v19, v5, 4, v2
    s_cmp_lt_u32 s3, 4
    s_barrier
    s_cbranch_scc1 L_ld2
    buffer_load_dwordx2 v[40:41], v15, s[8:11], s45 offen offset:0 sc1
    buffer_load_dwordx2 v[42:43], v15, s[8:11], s45 offen offset:2560 sc1
L_ld2:
    buffer_load_dwordx4 v[32:35], v14, s[8:11], s44 offen offset:0 sc1
    buffer_load_dwordx4 v[36:39], v14, s[8:11], s44 offen offset:2560 sc1
    ds_read_b128 v[68:71], v6 offset:52992
    s_mov_b32 s29, 262144
    s_cmp_eq_u32 s42, 0
    s_cselect_b32 s36, 5, 4
    s_mul_i32 s22, s42, 1280
    s_mul_i32 s21, s3, 327680
    s_add_u32 s22, s22, s21
    s_sub_u32 s23, 2621440, s22
    s_sub_u32 s21, s23, 512
    s_mov_b32 s48, s24
    s_and_b32 s49, s25, 0xffff
    s_mov_b32 s50, 2621440
    s_mov_b32 s51, 0x20000
    s_mov_b32 s38, 0x00ff00ff
    s_mov_b32 s39, 0x00ff00ff
    v_lshlrev_b32 v16, 1, v17
    v_lshl_add_u32 v16, v1, 5, v16
    v_sub_u32 v10, 760, v16
    s_cmp_ge_u32 s3, s36
    s_waitcnt lgkmcnt(0)
    s_cbranch_scc1 L_notab
    ds_read_b128 v[108:111], v6 offset:38656
    ds_read_b128 v[112:115], v6 offset:39680
    ds_read_b128 v[116:119], v6 offset:40704
L_pad4:
    s_cbranch_execz L_ret0
    ds_read_b128 v[120:123], v6 offset:41728
    ds_read_b128 v[124:127], v6 offset:42752
    ds_read_b128 v[128:131], v6 offset:43776
    ds_read_b128 v[132:135], v6 offset:44800
    ds_read_b64 v[136:137], v6 offset:45824
    v_mov_b32 v138, 0
    v_mov_b32 v139, 0
    ds_read_b128 v[140:143], v6 offset:46848
    ds_read_b128 v[144:147], v6 offset:47872
    ds_read_b64 v[148:149], v6 offset:48896
    v_mov_b32 v150, 0
    v_mov_b32 v151, 0
    ds_read_b128 v[152:155], v6 offset:49920
    ds_read_b128 v[156:159], v6 offset:50944
    ds_read_b64 v[160:161], v6 offset:51968
    v_mov_b32 v162, 0
    v_mov_b32 v163, 0
    s_lshl_b32 s43, s27, 2
    s_add_u32 s43, s26, s43
    s_add_u32 s43, s43, 1024
    v_and_b32 v2, 1, v1
    v_and_b32 v3, 12, v1
    v_bfe_u32 v9, v1, 1, 1
    v_mul_u32_u24 v5, 17, v17
    v_mul_u32_u24 v21, 4432, v9
    v_lshl_add_u32 v5, v2, 1, v5
    v_add_u32 v5, s43, v5
    v_lshl_add_u32 v5, v5, 4, v3
    v_add_u32 v23, 17728, v5
    v_add_u32 v21, v5, v21
    v_add_u32 v22, 8864, v21
    v_add_u32 v2, 1, v1
    v_lshrrev_b32 v3, 2, v6
    v_and_b32 v2, 15, v2
    v_cmp_eq_u32 vcc, 12, v17
    v_add_u32 v3, 64, v3
    v_lshlrev_b32 v2, 2, v2
    v_cndmask_b32 v13, v3, v2, vcc
L_notab:
    v_mov_b32 v4, 0
    s_cmp_lt_u32 s3, 4
L_chk:
    s_cbranch_scc1 L_a2
    s_waitcnt vmcnt(2)
    v_bfi_b32 v52, 1, v1, v40
    v_bfi_b32 v53, 1, v1, v41
L_pad5:
    s_cbranch_execz L_ret0
    v_bfi_b32 v54, 1, v1, v42
    v_bfi_b32 v55, 1, v1, v43
    v_bitop3_b32 v4, v40, v42, v24 bitop3:0x7e
    v_bitop3_b32 v5, v41, v43, v25 bitop3:0x7e
    v_mfma_f32_16x16x32_bf16 v[80:83], v[68:71], v[52:55], 0
    v_or_b32 v4, v4, v5
L_a2:
    s_waitcnt vmcnt(1)
    v_and_b32 v44, -2, v32
    v_or_b32 v45, 1, v33
    v_or_b32 v48, 1, v34
    v_and_b32 v49, -2, v35
    s_waitcnt vmcnt(0)
    v_or_b32 v46, 1, v36
    v_and_b32 v47, -2, v37
    v_and_b32 v50, -2, v38
    v_or_b32 v51, 1, v39
    v_mfma_f32_16x16x32_bf16 v[72:75], v[68:71], v[44:47], 0
    s_nop 0
    v_mfma_f32_16x16x32_bf16 v[76:79], v[68:71], v[48:51], 0
    s_cbranch_scc1 L_a3
    v_cvt_pk_bf16_f32 v104, v80, v81
    ds_write_b32 v19, v104 offset:0
    v_cvt_pk_bf16_f32 v105, v82, v83
    ds_write_b32 v19, v105 offset:32
L_a3:
    v_bitop3_b32 v2, v32, v36, v26 bitop3:0x7e
    v_bitop3_b32 v3, v33, v37, v27 bitop3:0x7e
    v_bitop3_b32 v5, v34, v38, v28 bitop3:0x7e
    v_bitop3_b32 v12, v35, v39, v29 bitop3:0x7e
    v_or3_b32 v2, v2, v3, v4
    v_or3_b32 v2, v2, v5, v12
    v_cvt_pk_bf16_f32 v96, v72, v73
    v_cvt_pk_bf16_f32 v97, v76, v77
    ds_write_b64 v18, v[96:97] offset:0
    v_cvt_pk_bf16_f32 v98, v74, v75
    v_cvt_pk_bf16_f32 v99, v78, v79
    ds_write_b64 v18, v[98:99] offset:32
    v_and_b32 v2, 1, v2
    v_cmp_ne_u32 vcc, 0, v2
    s_cmp_eq_u32 s42, 0
    s_nop 3
    s_cbranch_vccnz L_retry
L_ok:
    s_cbranch_scc1 L_row1024
L_row1024_out:
L_pad6:
    s_cbranch_execz L_ret0
    s_cmp_ge_u32 s3, s36
    s_waitcnt lgkmcnt(0)
    s_barrier
    s_cbranch_scc1 L_end
    ds_read2_b32 v[32:33], v21 offset0:0 offset1:68
    ds_read2_b32 v[34:35], v21 offset0:136 offset1:204
    ds_read2_b32 v[36:37], v22 offset0:0 offset1:68
    ds_read2_b32 v[38:39], v22 offset0:136 offset1:204
    ds_read2_b32 v[40:41], v23 offset0:0 offset1:68
    ds_read2_b32 v[42:43], v23 offset0:136 offset1:204
    v_mov_b32 v106, 0
    v_mov_b32 v107, 0
    s_and_b32 s41, s3, 3
    s_or_b32 s41, s41, s42
    s_mov_b64 vcc, 1
    s_waitcnt lgkmcnt(4)
    v_mfma_f32_16x16x32_bf16 v[72:75], v[32:35], v[60:63], 0
    v_mfma_f32_16x16x32_bf16 v[84:87], v[32:35], v[64:67], 0
    s_waitcnt lgkmcnt(2)
    v_mfma_f32_16x16x32_bf16 v[76:79], v[36:39], v[60:63], 0
    v_mfma_f32_16x16x32_bf16 v[88:91], v[36:39], v[64:67], 0
    s_waitcnt lgkmcnt(0)
    s_nop 2
    v_mul_f32 v44, v72, v108
    v_mul_f32 v46, v84, v108
    v_mul_f32 v45, v73, v109
    v_mul_f32 v47, v85, v109
    v_mfma_f32_16x16x32_bf16 v[80:83], v[40:43], v[60:63], 0
    v_mul_f32 v48, v74, v112
    v_mul_f32 v50, v86, v112
    v_mul_f32 v49, v75, v113
    v_mul_f32 v51, v87, v113
    v_fmac_f32 v44, v84, v110
    v_fma_f32 v46, -v72, v110, v46
    v_fmac_f32 v45, v85, v111
    v_fma_f32 v47, -v73, v111, v47
    v_mfma_f32_16x16x32_bf16 v[92:95], v[40:43], v[64:67], 0
    v_fmac_f32 v48, v86, v114
    v_fma_f32 v50, -v74, v114, v50
    v_fmac_f32 v49, v87, v115
    v_fma_f32 v51, -v75, v115, v51
    v_cvt_pk_bf16_f32 v96, v44, v46
    v_cvt_pk_bf16_f32 v97, v45, v47
    v_cvt_pk_bf16_f32 v98, v48, v50
    v_cvt_pk_bf16_f32 v99, v49, v51
L_pad7:
    s_cbranch_execz L_pad8
    v_mul_f32 v52, v76, v116
    v_mul_f32 v54, v88, v116
    v_mfma_f32_16x16x32_bf16 v[32:35], v[96:99], v[128:131], 0
    v_mul_f32 v53, v77, v117
    v_mul_f32 v55, v89, v117
    v_mul_f32 v56, v78, v120
    v_mul_f32 v58, v90, v120
    v_mul_f32 v57, v79, v121
    v_mul_f32 v59, v91, v121
    v_mfma_f32_16x16x32_bf16 v[36:39], v[96:99], v[140:143], 0
    v_fmac_f32 v52, v88, v118
    v_fma_f32 v54, -v76, v118, v54
    v_fmac_f32 v53, v89, v119
    v_fma_f32 v55, -v77, v119, v55
    v_fmac_f32 v56, v90, v122
    v_fma_f32 v58, -v78, v122, v58
    v_mfma_f32_16x16x32_bf16 v[40:43], v[96:99], v[152:155], 0
    v_fmac_f32 v57, v91, v123
    v_fma_f32 v59, -v79, v123, v59
    v_cvt_pk_bf16_f32 v100, v52, v54
    v_cvt_pk_bf16_f32 v101, v53, v55
    v_cvt_pk_bf16_f32 v102, v56, v58
    v_cvt_pk_bf16_f32 v103, v57, v59
    v_mul_f32 v44, v80, v124
    v_mul_f32 v46, v92, v124
    v_mfma_f32_16x16x32_bf16 v[32:35], v[100:103], v[132:135], v[32:35]
    v_mul_f32 v45, v81, v125
    v_mul_f32 v47, v93, v125
    v_fmac_f32 v44, v92, v126
    v_mfma_f32_16x16x32_bf16 v[36:39], v[100:103], v[144:147], v[36:39]
    v_fma_f32 v46, -v80, v126, v46
    v_fmac_f32 v45, v93, v127
    v_fma_f32 v47, -v81, v127, v47
    v_mfma_f32_16x16x32_bf16 v[40:43], v[100:103], v[156:159], v[40:43]
    v_cvt_pk_bf16_f32 v104, v44, v46
    v_cvt_pk_bf16_f32 v105, v45, v47
    s_nop 1
    v_mfma_f32_16x16x32_bf16 v[32:35], v[104:107], v[136:139], v[32:35]
    v_mfma_f32_16x16x32_bf16 v[36:39], v[104:107], v[148:151], v[36:39]
    v_mfma_f32_16x16x32_bf16 v[40:43], v[104:107], v[160:163], v[40:43]
    s_nop 5
    v_cvt_pk_bf16_f32 v72, v32, v33
L_pad8:
    s_cbranch_execz L_padx
    v_cndmask_b32 v2, v32, v36, vcc
    v_cndmask_b32 v3, v36, v40, vcc
    ds_bpermute_b32 v84, v13, v2
    ds_bpermute_b32 v88, v13, v3
    ds_bpermute_b32 v92, v13, v40
    v_cvt_pk_bf16_f32 v73, v34, v35
    buffer_store_dwordx2 v[72:73], v16, s[48:51], s22 offen offset:0 sc1
    v_cvt_pk_bf16_f32 v76, v36, v37
    v_cvt_pk_bf16_f32 v77, v38, v39
    buffer_store_dwordx2 v[76:77], v16, s[48:51], s22 offen offset:512 sc1
    v_cvt_pk_bf16_f32 v80, v40, v41
    v_cvt_pk_bf16_f32 v81, v42, v43
    s_cbranch_scc0 L_nomir
    v_cvt_pk_bf16_f32 v85, v34, v33
    v_cvt_pk_bf16_f32 v89, v38, v37
    v_cvt_pk_bf16_f32 v93, v42, v41
    s_waitcnt lgkmcnt(2)
    v_cvt_pk_bf16_f32 v84, v84, v35
    buffer_store_dwordx2 v[84:85], v10, s[48:51], s23 offen offset:512 sc1
    s_waitcnt lgkmcnt(1)
    v_cvt_pk_bf16_f32 v88, v88, v39
    buffer_store_dwordx2 v[88:89], v10, s[48:51], s23 offen offset:0 sc1
    s_waitcnt lgkmcnt(0)
    v_cvt_pk_bf16_f32 v92, v92, v43
    s_mov_b64 exec, s[38:39]
    buffer_store_dwordx2 v[92:93], v10, s[48:51], s21 offen offset:0 sc1
L_nomir:
    s_mov_b64 exec, s[38:39]
    buffer_store_dwordx2 v[80:81], v16, s[48:51], s22 offen offset:1024 sc1
L_reg1:
L_end:
    s_endpgm
L_row1024:
L_padx:
    s_cbranch_execz L_ret9
    v_xor_b32 v70, 0x80008000, v70
    v_xor_b32 v71, 0x80008000, v71
    s_cmp_lt_u32 s3, 4
    s_waitcnt lgkmcnt(0)
    v_mfma_f32_16x16x32_bf16 v[80:83], v[68:71], v[52:55], 0
    v_mfma_f32_16x16x32_bf16 v[72:75], v[68:71], v[44:47], 0
    v_mfma_f32_16x16x32_bf16 v[76:79], v[68:71], v[48:51], 0
    s_nop 7
    s_cbranch_scc1 L_a5
    v_cvt_pk_bf16_f32 v104, v80, v81
    ds_write_b32 v19, v104 offset:128
    v_cvt_pk_bf16_f32 v105, v82, v83
    ds_write_b32 v19, v105 offset:160
L_a5:
    v_cvt_pk_bf16_f32 v96, v72, v73
    v_cvt_pk_bf16_f32 v97, v76, v77
    ds_write_b64 v18, v[96:97] offset:128
    v_cvt_pk_bf16_f32 v98, v74, v75
    v_cvt_pk_bf16_f32 v99, v78, v79
    ds_write_b64 v18, v[98:99] offset:160
    s_branch L_row1024_out
L_w0f:
    v_sub_f32 v2, 0x3e400000, v4
    v_cmp_lt_u32 vcc, 8, v1
    v_sub_f32 v3, 0x3e3c0000, v4
    v_add_f32 v6, 0x3b800000, v4
    v_cndmask_b32 v4, v4, v2, vcc
    v_cmp_lt_u32 vcc, 7, v1
    v_mul_f32 v5, v7, v4
    v_cos_f32 v27, v5
    v_sin_f32 v28, v5
    v_fmamk_f32 v29, v4, 0x41000000, v5
    v_cos_f32 v30, v29
    v_sin_f32 v31, v29
    v_cvt_pk_bf16_f32 v44, v27, v28
    v_cvt_pk_bf16_f32 v52, -v28, v27
    v_fmamk_f32 v26, v4, 0x41800000, v5
    v_cos_f32 v27, v26
    v_sin_f32 v28, v26
    v_cvt_pk_bf16_f32 v45, v30, v31
    v_cvt_pk_bf16_f32 v53, -v31, v30
    v_fmamk_f32 v29, v4, 0x41c00000, v5
    v_cos_f32 v30, v29
    v_sin_f32 v31, v29
    v_cvt_pk_bf16_f32 v46, v27, v28
    v_cvt_pk_bf16_f32 v54, -v28, v27
    v_cvt_pk_bf16_f32 v47, v30, v31
    v_cvt_pk_bf16_f32 v55, -v31, v30
    v_cndmask_b32 v4, v6, v3, vcc
    v_mul_f32 v5, v7, v4
    v_cos_f32 v27, v5
    v_sin_f32 v28, v5
    v_fmamk_f32 v29, v4, 0x41000000, v5
    v_cos_f32 v30, v29
    v_sin_f32 v31, v29
    v_cvt_pk_bf16_f32 v48, v27, v28
    v_cvt_pk_bf16_f32 v56, -v28, v27
    v_fmamk_f32 v26, v4, 0x41800000, v5
    v_cos_f32 v27, v26
    v_sin_f32 v28, v26
    v_cvt_pk_bf16_f32 v49, v30, v31
    v_cvt_pk_bf16_f32 v57, -v31, v30
    v_fmamk_f32 v29, v4, 0x41c00000, v5
    v_cos_f32 v30, v29
    v_sin_f32 v31, v29
    v_cvt_pk_bf16_f32 v50, v27, v28
    v_cvt_pk_bf16_f32 v58, -v28, v27
    v_cvt_pk_bf16_f32 v51, v30, v31
    v_cvt_pk_bf16_f32 v59, -v31, v30
    s_branch L_w0f_back
L_hint:
    s_mov_b32 s16, s6
    s_and_b32 s17, s7, 0xffff
    s_mov_b32 s18, 1048576
    s_mov_b32 s19, 0x20000
    v_lshrrev_b32 v20, 7, v6
    s_lshl_b32 s31, s31, 8
    v_mul_u32_u24 v20, 8192, v20
    v_mov_b32 v80, s47
    v_mov_b32 v81, s47
    v_mov_b32 v82, s47
    v_mov_b32 v83, s47
    v_add_u32 v20, v20, v6
    s_waitcnt vmcnt(0)
    buffer_store_dwordx4 v[80:83], v20, s[16:19], s31 offen sc1
    s_branch L_hint_back
L_retry:
    s_sub_u32 s29, s29, 1
    s_cbranch_scc1 L_giveup
    s_cmp_lt_u32 s3, 4
    s_waitcnt lgkmcnt(0)
    s_cbranch_scc1 L_ld3
    buffer_load_dwordx2 v[40:41], v15, s[8:11], s45 offen offset:0 sc1
    buffer_load_dwordx2 v[42:43], v15, s[8:11], s45 offen offset:2560 sc1
L_ld3:
    buffer_load_dwordx4 v[32:35], v14, s[8:11], s44 offen offset:0 sc1
    buffer_load_dwordx4 v[36:39], v14, s[8:11], s44 offen offset:2560 sc1
    s_branch L_chk
L_giveup:
    s_cmp_eq_u32 s42, 0
    s_branch L_ok
L_svc:
    v_and_b32 v6, 63, v0
    v_lshlrev_b32 v6, 4, v6
    s_mov_b32 s16, s6
    s_and_b32 s17, s7, 0xffff
    s_mov_b32 s18, 1048576
    s_mov_b32 s19, 0x20000
    s_getreg_b32 s31, hwreg(HW_REG_XCC_ID)
    s_and_b32 s31, s31, 7
    s_mul_i32 s31, s31, 8320
    v_lshlrev_b32 v20, 4, v6
    s_mov_b32 s29, 262144
    v_cvt_f32_u32 v7, v7
    s_lshr_b32 s41, s2, 4
    s_lshl_b32 s41, s41, 3
    s_add_u32 s40, s28, s41
    s_lshr_b32 s41, s40, 4
    s_and_b32 s42, s40, 15
    s_lshl_b32 s42, s42, 4
    s_add_u32 s42, s42, s41
    s_sub_u32 s43, s42, 120
    s_and_b32 s41, s40, 0x78
    s_cmp_eq_u32 s41, 8
    s_cselect_b32 s42, s43, s42
    s_sub_u32 s43, 256, s42
    s_cmp_eq_u32 s40, 0
    s_cselect_b32 s43, 128, s43
    s_bitcmp1_b32 s2, 3
    s_cselect_b32 s42, s43, s42
    s_cselect_b32 s46, -1, 0
    v_and_b32 v2, 1, v1
    v_and_b32 v4, 12, v1
    v_bfe_u32 v9, v1, 1, 1
    v_lshl_add_u32 v4, v4, 6, s42
    v_add_u32 v5, v9, v2
    v_lshlrev_b32 v12, 4, v9
    v_cvt_f32_u32 v4, v4
    v_cvt_f32_u32 v5, v5
    v_bfrev_b32 v13, 1
    v_mul_f32 v4, 0x3a000000, v4
    v_add_f32 v5, v5, v5
    v_lshrrev_b32 v12, v12, v13
    v_fma_f32 v5, v7, v4, v5
    v_and_b32 v13, s46, v12
    v_mul_f32 v5, 0x3e000000, v5
    v_xor_b32 v11, v13, v12
    v_cos_f32 v27, v5
    v_sin_f32 v28, v5
    v_add_f32 v29, v4, v5
    v_cos_f32 v30, v29
    v_sin_f32 v31, v29
    s_cmp_eq_u32 s40, 0
    s_cbranch_scc1 L_self
    v_cvt_pk_bf16_f32 v68, v27, v28
    v_xor_b32 v69, v68, v11
    v_xor_b32 v68, v68, v13
    v_cvt_pk_bf16_f32 v70, v30, v31
    v_xor_b32 v71, v70, v11
    v_xor_b32 v70, v70, v13
    s_branch L_self_out
L_self:
    v_lshrrev_b32 v12, 15, v12
    v_mul_u32_u24 v12, 0xffff, v12
    v_add_f32 v27, v27, v27
    v_add_f32 v28, v28, v28
    v_cvt_pk_bf16_f32 v68, v27, v28
    v_bfi_b32 v68, v12, 0, v68
    v_and_b32 v69, s46, v68
    v_bfi_b32 v68, s46, 0, v68
    v_add_f32 v30, v30, v30
    v_add_f32 v31, v31, v31
    v_cvt_pk_bf16_f32 v70, v30, v31
    v_bfi_b32 v70, v12, 0, v70
    v_and_b32 v71, s46, v70
    v_bfi_b32 v70, s46, 0, v70
L_self_out:
    ds_write_b128 v6, v[68:71] offset:52992
    s_mov_b64 exec, 0
    s_branch L_pad7
L_ret9:
    s_mov_b64 exec, -1
    s_waitcnt lgkmcnt(0)
    v_not_b32 v8, s47
    s_setprio 2
    v_not_b32 v72, s47
    v_not_b32 v73, s47
    v_not_b32 v74, s47
    v_not_b32 v75, s47
    s_lshl_b32 s30, s2, 6
    s_add_u32 s30, s30, 528384
    s_mov_b64 exec, 15
    s_barrier
    buffer_store_dwordx4 v[72:75], v6, s[16:19], s30 offen sc1
    s_mov_b64 exec, 0x3ff
    s_barrier
L_poll_loop:
    buffer_load_dword v80, v20, s[16:19], s31 offen sc1
    s_sub_u32 s29, s29, 1
    s_waitcnt vmcnt(0)
    s_cbranch_scc1 L_poll_out
    v_cmpx_ne_u32 vcc, v8, v80
    s_nop 4
    s_cbranch_execz L_poll_out
    s_sleep 3
    s_branch L_poll_loop
L_poll_out:
    s_barrier
    s_cmp_lg_u32 s2, 160
    s_cbranch_scc1 L_svc_end
    s_mov_b64 exec, -1
    s_mov_b32 s21, 528384
    s_mov_b32 s29, 262144
    s_setprio 0
    buffer_load_dword v80, v20, s[16:19], s21 offen offset:0 sc1
    buffer_load_dword v81, v20, s[16:19], s21 offen offset:64 sc1
    buffer_load_dword v82, v20, s[16:19], s21 offen offset:128 sc1
    buffer_load_dword v83, v20, s[16:19], s21 offen offset:192 sc1
    s_barrier
    s_branch L_pub_chk
L_pub_loop:
    buffer_load_dword v80, v20, s[16:19], s21 offen offset:0 sc1
    buffer_load_dword v81, v20, s[16:19], s21 offen offset:64 sc1
    buffer_load_dword v82, v20, s[16:19], s21 offen offset:128 sc1
    buffer_load_dword v83, v20, s[16:19], s21 offen offset:192 sc1
L_pub_chk:
    s_sub_u32 s29, s29, 1
    s_waitcnt vmcnt(0)
    s_cbranch_scc1 L_pub_out
    v_bitop3_b32 v80, v80, v81, v8 bitop3:0x7e
    v_bitop3_b32 v82, v82, v83, v8 bitop3:0x7e
    v_or_b32 v80, v80, v82
    v_cmpx_ne_u32 vcc, 0, v80
    s_nop 4
    s_cbranch_execnz L_pub_loop
L_pub_out:
    s_mov_b64 exec, 1
    v_mov_b32 v20, 524288
    buffer_store_dword v8, v20, s[16:19], 0 offen
L_svc_end:
L_done:
    s_endpgm
.section .rodata,"a"
.p2align 6
.amdhsa_kernel standalone__spectral_fnet__prompt_kernel
  .amdhsa_next_free_vgpr 164
  .amdhsa_next_free_sgpr 56
  .amdhsa_accum_offset 164
  .amdhsa_group_segment_fixed_size 0
  .amdhsa_kernarg_size 64
  .amdhsa_user_sgpr_count 2
  .amdhsa_user_sgpr_kernarg_segment_ptr 1
  .amdhsa_system_sgpr_workgroup_id_x 1
.end_amdhsa_kernel
```
